```python
import torch

def _softmax(x, axis=-1):
    return torch.softmax(x, dim=axis)
def _gelu(x):
    return torch.nn.functional.gelu(x, approximate="tanh")
def _silu(x):
    return torch.nn.functional.silu(x)
def _sigmoid(x):
    return torch.sigmoid(x)
def _layernorm(x, axis=-1, eps=1e-5):
    m = x.mean(dim=axis, keepdim=True)
    v = x.var(dim=axis, keepdim=True, unbiased=False)
    return (x - m) / torch.sqrt(v + eps)
def _scatter_add(tgt, idx, src, axis=0):
    return tgt.clone().index_add_(axis, idx, src)
def _segment_sum(src, seg, n):
    out = torch.zeros((n,) + src.shape[1:], dtype=src.dtype)
    return out.index_add_(0, seg, src)
def _pad(x, pw):
    flat = tuple(v for pair in reversed(pw) for v in pair)
    return torch.nn.functional.pad(x, flat)

kernel_name = 'standalone__ragged_sequences_packed_sequences__ragged'

def setup_inputs():

    _w = (lambda a: (lambda t: t.to(torch.bfloat16) if t.is_floating_point() else t)(torch.as_tensor(a)))
    cu = torch.tensor([0, 400, 516, 964, 1456, 1702, 1900, 2021, 2266], dtype=torch.int64)
    T = int(cu[-1])
    H, D = 16, 128
    lens = torch.diff(cu)
    seg_ids = torch.repeat_interleave(torch.arange(len(lens), dtype=torch.int64), lens)
    return {
        "q": _w((lambda *s: torch.randn(*s, dtype=torch.bfloat16) * 0.8)(T, H, D)),
        "k": _w((lambda *s: torch.randn(*s, dtype=torch.bfloat16) * 0.8)(T, H, D)),
        "v": _w((lambda *s: torch.randn(*s, dtype=torch.bfloat16) * 0.05)(T, H, D)),
        "seg_ids": _w(seg_ids),
    }

def reference(q, k, v, seg_ids):
    T, H, D = q.shape
    scale = D ** -0.5
    same_seq = seg_ids[:, None] == seg_ids[None, :]
    logits = torch.einsum("qhd,khd->hqk", q, k) * scale
    bias = (1.0 - (lambda x, dt: x.to(dt))(same_seq, q.dtype)) * (-1e9)
    p = _softmax(logits + bias[None, :, :], axis=-1)
    return torch.einsum("hqk,khd->qhd", p, v)
```

```asm
; @launch grid=(256,1,1) block=(512,1,1) lds=156800
.amdgcn_target "amdgcn-amd-amdhsa--gfx950"
.text
.globl standalone__ragged_sequences_packed_sequences__ragged_kernel
.p2align 8
.type standalone__ragged_sequences_packed_sequences__ragged_kernel,@function
standalone__ragged_sequences_packed_sequences__ragged_kernel:
    s_cmp_ge_u32 s2, 256
    s_cbranch_scc1 L_end
    v_lshrrev_b32 v240, 6, v0
    v_mov_b32 v11, 156672
    v_mov_b32 v13, 0
    v_add_u32 v241, 7, v240
    v_and_b32 v241, 7, v241
    v_lshl_add_u32 v14, v241, 2, v11
    ds_write_b32 v11, v13
    ds_write_b32 v14, v13 offset:16
    v_add_u32 v14, 16, v14
    v_and_b32 v1, 63, v0
    v_readfirstlane_b32 s39, v240
    s_waitcnt lgkmcnt(0)
    s_load_dwordx8 s[4:11], s[0:1], 0
    s_load_dwordx2 s[12:13], s[0:1], 32
    s_barrier
    s_and_b32 s43, s2, 7
    s_lshl_b32 s43, s43, 1
    s_bfe_u32 s44, s2, 0x10003
    s_add_u32 s43, s43, s44
    s_lshl_b32 s40, s43, 8
    s_lshr_b32 s46, s2, 4
    s_mov_b32 s32, 0x106a65b0
    s_mov_b32 s33, 0x86a65b0
    s_cmp_eq_u32 s46, 1
    s_cselect_b32 s32, 0x108da7e5, s32
    s_cselect_b32 s33, 0x88da7e5, s33
    s_cmp_eq_u32 s46, 2
    s_cselect_b32 s32, 0x1076c6a6, s32
    s_cselect_b32 s33, 0x776c6a6, s33
    s_cmp_eq_u32 s46, 3
    s_cselect_b32 s32, 0x5b03c4, s32
    s_cselect_b32 s33, 0x104443c4, s33
    s_cmp_eq_u32 s46, 4
    s_cselect_b32 s32, 0x5b03c4, s32
    s_cselect_b32 s33, 0x104c4444, s33
    s_cmp_eq_u32 s46, 5
    s_cselect_b32 s32, 0x5b03c4, s32
    s_cselect_b32 s33, 0x105444c4, s33
    s_cmp_eq_u32 s46, 6
    s_cselect_b32 s32, 0x5b03c4, s32
    s_cselect_b32 s33, 0x105b0544, s33
    s_cmp_eq_u32 s46, 7
    s_cselect_b32 s32, 0x3c4204, s32
    s_cselect_b32 s33, 0xe284204, s33
    s_cmp_eq_u32 s46, 8
    s_cselect_b32 s32, 0x3c4204, s32
    s_cselect_b32 s33, 0xe304284, s33
    s_cmp_eq_u32 s46, 9
    s_cselect_b32 s32, 0x190000, s32
    s_cselect_b32 s33, 0xd080000, s33
    s_cmp_eq_u32 s46, 10
    s_cselect_b32 s32, 0x3c4204, s32
    s_cselect_b32 s33, 0xe364304, s33
    s_cmp_eq_u32 s46, 11
    s_cselect_b32 s32, 0x3c4204, s32
    s_cselect_b32 s33, 0xe3c4364, s33
    s_cmp_eq_u32 s46, 12
    s_cselect_b32 s32, 0x190000, s32
    s_cselect_b32 s33, 0xd0e0080, s33
    s_cmp_eq_u32 s46, 13
    s_cselect_b32 s32, 0x190000, s32
    s_cselect_b32 s33, 0xd1400e0, s33
    s_cmp_eq_u32 s46, 14
    s_cselect_b32 s32, 0x190000, s32
    s_cselect_b32 s33, 0xd190140, s33
    s_cmp_eq_u32 s46, 15
    s_cselect_b32 s32, 0x20204190, s32
    s_cselect_b32 s33, 0x8204190, s33
    s_and_b32 s34, s32, 0xfff
    s_bfe_u32 s35, s32, 0xc000c
    s_bfe_u32 s37, s32, 0x40018
    s_lshr_b32 s38, s32, 28
    s_and_b32 s41, s33, 0xfff
    s_bfe_u32 s42, s33, 0xc000c
    s_lshr_b32 s36, s33, 24
    s_add_u32 s74, s39, 7
    s_and_b32 s74, s74, 7
    s_lshl_b32 s43, s74, 5
    s_add_u32 s41, s41, s43
    s_lshr_b32 s44, s74, 2
    s_lshl_b32 s45, s44, 2
    s_add_u32 s45, s45, s38
    s_mov_b32 s47, s36
    s_mov_b32 s55, 0
    s_sub_u32 s50, s35, s34
    s_cmp_eq_u32 s38, 2
    s_cselect_b32 s47, 4, s47
    s_add_u32 s43, s43, 1772
    s_cmp_eq_u32 s45, 6
    s_cselect_b32 s41, s43, s41
    s_cselect_b32 s42, 2021, s42
    s_cselect_b32 s55, 4, s55
    s_cselect_b32 s50, 121, s50
    s_cmp_eq_u32 s45, 4
    s_cselect_b32 s42, 0, s42
    v_and_b32 v244, 31, v1
    v_lshrrev_b32 v245, 5, v1
    v_lshrrev_b32 v240, 4, v1
    v_and_b32 v241, 15, v1
    v_lshlrev_b32 v242, 15, v240
    v_lshl_add_u32 v6, v241, 4, v242
    v_and_b32 v243, 1, v240
    v_lshlrev_b32 v243, 7, v243
    v_xor_b32 v5, v6, v243
    s_mul_i32 s73, s74, 8320
    s_add_u32 s73, s73, 33280
    s_mul_i32 s43, s39, 8704
    s_add_u32 s43, s43, 66560
    s_cmp_ge_u32 s74, 4
    s_cselect_b32 s73, s43, s73
    s_cmp_eq_u32 s39, 0
    s_cselect_b32 s73, 101376, s73
    s_lshl_b32 s44, s41, 12
    s_add_u32 s44, s44, s40
    s_sub_i32 s43, s42, s41
    s_lshl_b32 s43, s43, 12
    s_sub_i32 s43, s43, 3840
    s_max_i32 s18, s43, 0
    s_mov_b32 s19, 0x00020000
    s_mov_b32 s30, s18
    s_mov_b32 s31, 0x00020000
    s_waitcnt lgkmcnt(0)
    s_add_u32 s16, s4, s44
    s_addc_u32 s17, s5, 0
    s_add_u32 s28, s12, s44
    s_addc_u32 s29, s13, 0
    s_cmp_eq_u32 s39, 0
    s_cbranch_scc1 L_loader
    s_cmp_lt_u32 s41, s42
    s_cbranch_scc0 L_noqc
    s_add_u32 m0, s73, 0
    s_mov_b32 s43, 0
    buffer_load_dwordx4 v5, s[16:19], s43 offen  lds
    s_add_u32 m0, s73, 1040
    s_mov_b32 s43, 4096
    buffer_load_dwordx4 v5, s[16:19], s43 offen  lds
    s_add_u32 m0, s73, 2080
    s_mov_b32 s43, 8192
    buffer_load_dwordx4 v5, s[16:19], s43 offen  lds
    s_add_u32 m0, s73, 3120
    s_mov_b32 s43, 12288
    buffer_load_dwordx4 v5, s[16:19], s43 offen  lds
    s_add_u32 m0, s73, 4160
    s_mov_b32 s43, 16384
    buffer_load_dwordx4 v5, s[16:19], s43 offen  lds
    s_add_u32 m0, s73, 5200
    s_mov_b32 s43, 20480
    buffer_load_dwordx4 v5, s[16:19], s43 offen  lds
    s_add_u32 m0, s73, 6240
    s_mov_b32 s43, 24576
    buffer_load_dwordx4 v5, s[16:19], s43 offen  lds
    s_add_u32 m0, s73, 7280
    s_mov_b32 s43, 28672
    buffer_load_dwordx4 v5, s[16:19], s43 offen  lds
L_noqc:
    s_lshl_b32 s43, s38, 4
    s_add_u32 s43, s43, s39
    s_cmp_lt_u32 s43, 20
    s_cbranch_scc1 L_noq7
    s_and_b32 s43, s43, 15
    s_cmp_eq_u32 s43, 4
    s_cbranch_scc0 L_noq7
    s_add_u32 s43, s41, 128
    s_mov_b32 s45, s42
    s_cmp_eq_u32 s38, 2
    s_cselect_b32 s43, 1996, s43
    s_cselect_b32 s45, 2021, s45
    s_sub_i32 s45, s45, s43
    s_lshl_b32 s45, s45, 12
    s_sub_i32 s45, s45, 3840
    s_max_i32 s22, s45, 0
    s_mov_b32 s23, 0x00020000
    s_lshl_b32 s43, s43, 12
    s_add_u32 s43, s43, s40
    s_add_u32 s20, s4, s43
    s_addc_u32 s21, s5, 0
    s_mov_b32 m0, 101376
    s_mov_b32 s43, 0
    buffer_load_dwordx4 v5, s[20:23], s43 offen  lds
    s_mov_b32 m0, 102416
    s_mov_b32 s43, 4096
    buffer_load_dwordx4 v5, s[20:23], s43 offen  lds
    s_mov_b32 m0, 103456
    s_mov_b32 s43, 8192
    buffer_load_dwordx4 v5, s[20:23], s43 offen  lds
    s_mov_b32 m0, 104496
    s_mov_b32 s43, 12288
    buffer_load_dwordx4 v5, s[20:23], s43 offen  lds
    s_mov_b32 m0, 105536
    s_mov_b32 s43, 16384
    buffer_load_dwordx4 v5, s[20:23], s43 offen  lds
    s_mov_b32 m0, 106576
    s_mov_b32 s43, 20480
    buffer_load_dwordx4 v5, s[20:23], s43 offen  lds
    s_mov_b32 m0, 107616
    s_mov_b32 s43, 24576
    buffer_load_dwordx4 v5, s[20:23], s43 offen  lds
    s_mov_b32 m0, 108656
    s_mov_b32 s43, 28672
    buffer_load_dwordx4 v5, s[20:23], s43 offen  lds
L_noq7:
    v_and_b32 v247, 7, v244
    v_mul_u32_u24 v3, 1040, v247
    v_lshrrev_b32 v247, 3, v244
    v_lshl_add_u32 v3, v247, 8, v3
    v_and_b32 v247, 1, v247
    v_xor_b32 v247, v247, v245
    v_lshl_add_u32 v3, v247, 7, v3
    v_add_u32 v246, s73, v3
L_compute:
    s_cmp_lt_u32 s41, s42
    s_cbranch_scc0 L_idle
    v_lshlrev_b32 v2, 2, v245
    v_bfe_u32 v247, v1, 2, 2
    v_add_u32 v247, v247, v2
    v_mul_u32_u24 v4, 1088, v247
    v_and_b32 v247, 1, v1
    v_lshl_add_u32 v4, v247, 5, v4
    v_bfe_u32 v247, v1, 4, 1
    v_lshl_add_u32 v4, v247, 4, v4
    v_bfe_u32 v247, v1, 1, 1
    v_lshl_add_u32 v4, v247, 3, v4
    v_add_u32 v4, 66560, v4
    v_mov_b32 v10, 0xff800000
    v_mov_b32 v7, 0
    v_mov_b32 v252, 0
    v_mov_b32 v253, 0
    v_mov_b32 v254, 0
    v_mov_b32 v255, 0
    v_mov_b32 v9, 0
    s_nop 0
    v_mfma_f32_32x32x16_bf16 v[48:63], v[252:255], v[252:255], 0
    v_mfma_f32_32x32x16_bf16 v[64:79], v[252:255], v[252:255], 0
    v_mfma_f32_32x32x16_bf16 v[80:95], v[252:255], v[252:255], 0
    v_mfma_f32_32x32x16_bf16 v[96:111], v[252:255], v[252:255], 0
    v_mfma_f32_32x32x16_bf16 v[160:175], v[252:255], v[252:255], 0
    s_sub_u32 s43, s47, 1
    s_sub_u32 s49, s43, s37
    s_lshl_b32 s43, s43, 5
    s_sub_u32 s50, s50, s43
    s_cmp_ge_u32 s50, 32
    s_cselect_b32 s49, s47, s49
    s_add_u32 s48, s55, 4
    s_add_u32 s49, s49, s48
    s_add_u32 s47, s47, s48
    s_mul_i32 s53, s55, 8320
    s_mul_i32 s54, s55, 8704
    v_add_u32 v5, s53, v3
    v_add_u32 v6, s54, v4
    s_add_u32 s51, s55, 3
    s_cmp_eq_u32 s55, 0
    s_cselect_b32 s45, 2, s51
    s_cmp_eq_u32 s39, 0
    s_cbranch_scc1 L_qdone
    s_waitcnt vmcnt(0)
    ds_read_b128 v[16:19], v246 offset:0
    ds_read_b128 v[20:23], v246 offset:16
    ds_read_b128 v[24:27], v246 offset:32
    ds_read_b128 v[28:31], v246 offset:48
    ds_read_b128 v[32:35], v246 offset:64
    ds_read_b128 v[36:39], v246 offset:80
    ds_read_b128 v[40:43], v246 offset:96
    ds_read_b128 v[44:47], v246 offset:112
    v_mov_b32 v12, 1
    s_waitcnt lgkmcnt(0)
    ds_write_b32 v14, v12
L_qdone:
    s_mov_b32 s86, 0x3e0293ee
    s_mov_b32 s87, 0x3e0293ee
    s_mov_b32 s44, 0xffff0000
    v_lshlrev_b32 v240, 16, v16
    v_and_b32 v241, s44, v16
    v_lshlrev_b32 v242, 16, v17
    v_and_b32 v243, s44, v17
    v_lshlrev_b32 v244, 16, v18
    v_and_b32 v245, s44, v18
    v_lshlrev_b32 v246, 16, v19
    v_and_b32 v247, s44, v19
    v_mul_f32 v240, s86, v240
    v_mul_f32 v241, s86, v241
    v_mul_f32 v242, s86, v242
    v_mul_f32 v243, s86, v243
    v_mul_f32 v244, s86, v244
    v_mul_f32 v245, s86, v245
    v_mul_f32 v246, s86, v246
    v_mul_f32 v247, s86, v247
    v_cvt_pk_bf16_f32 v16, v240, v241
    v_cvt_pk_bf16_f32 v17, v242, v243
    v_cvt_pk_bf16_f32 v18, v244, v245
    v_cvt_pk_bf16_f32 v19, v246, v247
    v_lshlrev_b32 v240, 16, v20
    v_and_b32 v241, s44, v20
    v_lshlrev_b32 v242, 16, v21
    v_and_b32 v243, s44, v21
    v_lshlrev_b32 v244, 16, v22
    v_and_b32 v245, s44, v22
    v_lshlrev_b32 v246, 16, v23
    v_and_b32 v247, s44, v23
    v_mul_f32 v240, s86, v240
    v_mul_f32 v241, s86, v241
    v_mul_f32 v242, s86, v242
    v_mul_f32 v243, s86, v243
    v_mul_f32 v244, s86, v244
    v_mul_f32 v245, s86, v245
    v_mul_f32 v246, s86, v246
    v_mul_f32 v247, s86, v247
    v_cvt_pk_bf16_f32 v20, v240, v241
    v_cvt_pk_bf16_f32 v21, v242, v243
    v_cvt_pk_bf16_f32 v22, v244, v245
    v_cvt_pk_bf16_f32 v23, v246, v247
    v_lshlrev_b32 v240, 16, v24
    v_and_b32 v241, s44, v24
    v_lshlrev_b32 v242, 16, v25
    v_and_b32 v243, s44, v25
    v_lshlrev_b32 v244, 16, v26
    v_and_b32 v245, s44, v26
    v_lshlrev_b32 v246, 16, v27
    v_and_b32 v247, s44, v27
    v_mul_f32 v240, s86, v240
    v_mul_f32 v241, s86, v241
    v_mul_f32 v242, s86, v242
    v_mul_f32 v243, s86, v243
    v_mul_f32 v244, s86, v244
    v_mul_f32 v245, s86, v245
    v_mul_f32 v246, s86, v246
    v_mul_f32 v247, s86, v247
    v_cvt_pk_bf16_f32 v24, v240, v241
    v_cvt_pk_bf16_f32 v25, v242, v243
    v_cvt_pk_bf16_f32 v26, v244, v245
    v_cvt_pk_bf16_f32 v27, v246, v247
    v_lshlrev_b32 v240, 16, v28
    v_and_b32 v241, s44, v28
    v_lshlrev_b32 v242, 16, v29
    v_and_b32 v243, s44, v29
    v_lshlrev_b32 v244, 16, v30
    v_and_b32 v245, s44, v30
    v_lshlrev_b32 v246, 16, v31
    v_and_b32 v247, s44, v31
    v_mul_f32 v240, s86, v240
    v_mul_f32 v241, s86, v241
    v_mul_f32 v242, s86, v242
    v_mul_f32 v243, s86, v243
    v_mul_f32 v244, s86, v244
    v_mul_f32 v245, s86, v245
    v_mul_f32 v246, s86, v246
    v_mul_f32 v247, s86, v247
    v_cvt_pk_bf16_f32 v28, v240, v241
    v_cvt_pk_bf16_f32 v29, v242, v243
    v_cvt_pk_bf16_f32 v30, v244, v245
    v_cvt_pk_bf16_f32 v31, v246, v247
    v_lshlrev_b32 v240, 16, v32
    v_and_b32 v241, s44, v32
    v_lshlrev_b32 v242, 16, v33
    v_and_b32 v243, s44, v33
    v_lshlrev_b32 v244, 16, v34
    v_and_b32 v245, s44, v34
    v_lshlrev_b32 v246, 16, v35
    v_and_b32 v247, s44, v35
    v_mul_f32 v240, s86, v240
    v_mul_f32 v241, s86, v241
    v_mul_f32 v242, s86, v242
    v_mul_f32 v243, s86, v243
    v_mul_f32 v244, s86, v244
    v_mul_f32 v245, s86, v245
    v_mul_f32 v246, s86, v246
    v_mul_f32 v247, s86, v247
    v_cvt_pk_bf16_f32 v32, v240, v241
    v_cvt_pk_bf16_f32 v33, v242, v243
    v_cvt_pk_bf16_f32 v34, v244, v245
    v_cvt_pk_bf16_f32 v35, v246, v247
    v_lshlrev_b32 v240, 16, v36
    v_and_b32 v241, s44, v36
    v_lshlrev_b32 v242, 16, v37
    v_and_b32 v243, s44, v37
    v_lshlrev_b32 v244, 16, v38
    v_and_b32 v245, s44, v38
    v_lshlrev_b32 v246, 16, v39
    v_and_b32 v247, s44, v39
    v_mul_f32 v240, s86, v240
    v_mul_f32 v241, s86, v241
    v_mul_f32 v242, s86, v242
    v_mul_f32 v243, s86, v243
    v_mul_f32 v244, s86, v244
    v_mul_f32 v245, s86, v245
    v_mul_f32 v246, s86, v246
    v_mul_f32 v247, s86, v247
    v_cvt_pk_bf16_f32 v36, v240, v241
    v_cvt_pk_bf16_f32 v37, v242, v243
    v_cvt_pk_bf16_f32 v38, v244, v245
    v_cvt_pk_bf16_f32 v39, v246, v247
    v_lshlrev_b32 v240, 16, v40
    v_and_b32 v241, s44, v40
    v_lshlrev_b32 v242, 16, v41
    v_and_b32 v243, s44, v41
    v_lshlrev_b32 v244, 16, v42
    v_and_b32 v245, s44, v42
    v_lshlrev_b32 v246, 16, v43
    v_and_b32 v247, s44, v43
    v_mul_f32 v240, s86, v240
    v_mul_f32 v241, s86, v241
    v_mul_f32 v242, s86, v242
    v_mul_f32 v243, s86, v243
    v_mul_f32 v244, s86, v244
    v_mul_f32 v245, s86, v245
    v_mul_f32 v246, s86, v246
    v_mul_f32 v247, s86, v247
    v_cvt_pk_bf16_f32 v40, v240, v241
    v_cvt_pk_bf16_f32 v41, v242, v243
    v_cvt_pk_bf16_f32 v42, v244, v245
    v_cvt_pk_bf16_f32 v43, v246, v247
    v_lshlrev_b32 v240, 16, v44
    v_and_b32 v241, s44, v44
    v_lshlrev_b32 v242, 16, v45
    v_and_b32 v243, s44, v45
    v_lshlrev_b32 v244, 16, v46
    v_and_b32 v245, s44, v46
    v_lshlrev_b32 v246, 16, v47
    v_and_b32 v247, s44, v47
    v_mul_f32 v240, s86, v240
    v_mul_f32 v241, s86, v241
    v_mul_f32 v242, s86, v242
    v_mul_f32 v243, s86, v243
    v_mul_f32 v244, s86, v244
    v_mul_f32 v245, s86, v245
    v_mul_f32 v246, s86, v246
    v_mul_f32 v247, s86, v247
    v_cvt_pk_bf16_f32 v44, v240, v241
    v_cvt_pk_bf16_f32 v45, v242, v243
    v_cvt_pk_bf16_f32 v46, v244, v245
    v_cvt_pk_bf16_f32 v47, v246, v247
L_poll_pre:
    ds_read_b32 v13, v11
    s_waitcnt lgkmcnt(0)
    v_readfirstlane_b32 s52, v13
    s_cmp_ge_u32 s52, s45
    s_cbranch_scc1 L_poll_pre_done
    s_sleep 1
    s_branch L_poll_pre
L_poll_pre_done:
    ds_read_b128 v[176:179], v5 offset:0
    ds_read_b128 v[180:183], v5 offset:16
    ds_read_b128 v[184:187], v5 offset:32
    ds_read_b128 v[188:191], v5 offset:48
    ds_read_b128 v[192:195], v5 offset:64
    ds_read_b128 v[196:199], v5 offset:80
    ds_read_b128 v[200:203], v5 offset:96
    ds_read_b128 v[204:207], v5 offset:112
    s_waitcnt lgkmcnt(7)
    v_mfma_f32_32x32x16_bf16 v[112:127], v[176:179], v[16:19], 0
    s_waitcnt lgkmcnt(6)
    v_mfma_f32_32x32x16_bf16 v[112:127], v[180:183], v[20:23], v[112:127]
    ds_read_b128 v[176:179], v5 offset:8320
    s_waitcnt lgkmcnt(6)
    v_mfma_f32_32x32x16_bf16 v[112:127], v[184:187], v[24:27], v[112:127]
    ds_read_b128 v[180:183], v5 offset:8336
    s_waitcnt lgkmcnt(6)
    v_mfma_f32_32x32x16_bf16 v[112:127], v[188:191], v[28:31], v[112:127]
    ds_read_b128 v[184:187], v5 offset:8352
    s_waitcnt lgkmcnt(6)
    v_mfma_f32_32x32x16_bf16 v[112:127], v[192:195], v[32:35], v[112:127]
    ds_read_b128 v[188:191], v5 offset:8368
    s_waitcnt lgkmcnt(6)
    v_mfma_f32_32x32x16_bf16 v[112:127], v[196:199], v[36:39], v[112:127]
    ds_read_b128 v[192:195], v5 offset:8384
    s_waitcnt lgkmcnt(6)
    v_mfma_f32_32x32x16_bf16 v[112:127], v[200:203], v[40:43], v[112:127]
    ds_read_b128 v[196:199], v5 offset:8400
    s_waitcnt lgkmcnt(6)
    v_mfma_f32_32x32x16_bf16 v[112:127], v[204:207], v[44:47], v[112:127]
    ds_read_b128 v[200:203], v5 offset:8416
    ds_read_b128 v[204:207], v5 offset:8432
    s_add_u32 s53, s53, 16640
    s_cmp_eq_u32 s53, 66560
    s_cselect_b32 s53, 0, s53
    v_add_u32 v5, s53, v3
    s_nop 7
    s_cmp_eq_u32 s48, s49
    s_cbranch_scc1 L_mask_pre
L_maskdone_pre:
    s_waitcnt lgkmcnt(0)
    v_mfma_f32_32x32x16_bf16 v[128:143], v[176:179], v[16:19], v[160:175]
    ds_read_b32 v13, v11
    v_exp_f32 v252, v112
    v_exp_f32 v253, v113
    v_mfma_f32_32x32x16_bf16 v[128:143], v[180:183], v[20:23], v[128:143]
    v_exp_f32 v254, v114
    v_add_f32 v8, v252, v253
    v_cvt_pk_bf16_f32 v144, v252, v253
    v_exp_f32 v255, v115
    v_add_f32 v8, v8, v254
    v_mfma_f32_32x32x16_bf16 v[128:143], v[184:187], v[24:27], v[128:143]
    v_exp_f32 v252, v116
    v_add_f32 v8, v8, v255
    v_cvt_pk_bf16_f32 v145, v254, v255
    v_exp_f32 v253, v117
    v_mfma_f32_32x32x16_bf16 v[128:143], v[188:191], v[28:31], v[128:143]
    v_add_f32 v8, v8, v252
    v_exp_f32 v254, v118
    v_add_f32 v8, v8, v253
    v_cvt_pk_bf16_f32 v146, v252, v253
    v_exp_f32 v255, v119
    v_mfma_f32_32x32x16_bf16 v[128:143], v[192:195], v[32:35], v[128:143]
    v_add_f32 v8, v8, v254
    v_exp_f32 v252, v120
    v_add_f32 v8, v8, v255
    v_cvt_pk_bf16_f32 v147, v254, v255
    v_mfma_f32_32x32x16_bf16 v[128:143], v[196:199], v[36:39], v[128:143]
    v_exp_f32 v253, v121
    v_add_f32 v8, v8, v252
    v_exp_f32 v254, v122
    v_add_f32 v8, v8, v253
    v_cvt_pk_bf16_f32 v148, v252, v253
    v_mfma_f32_32x32x16_bf16 v[128:143], v[200:203], v[40:43], v[128:143]
    v_exp_f32 v255, v123
    v_add_f32 v8, v8, v254
    v_exp_f32 v252, v124
    v_add_f32 v8, v8, v255
    v_mfma_f32_32x32x16_bf16 v[128:143], v[204:207], v[44:47], v[128:143]
    v_cvt_pk_bf16_f32 v149, v254, v255
    v_exp_f32 v253, v125
    v_add_f32 v8, v8, v252
    v_exp_f32 v254, v126
    v_add_f32 v8, v8, v253
    s_waitcnt lgkmcnt(0)
    v_readfirstlane_b32 s52, v13
    v_cvt_pk_bf16_f32 v150, v252, v253
    v_exp_f32 v255, v127
    v_add_f32 v8, v8, v254
    v_add_u32 v12, 1, v12
    v_add_f32 v8, v8, v255
    v_cvt_pk_bf16_f32 v151, v254, v255
    v_cmp_lt_f32 vcc, 0x44800000, v8
    v_mov_b32 v240, 0x3a800000
    s_cmp_ge_u32 s52, s48
    s_cbranch_scc0 L_poll_i0
L_polldone_i0:
    ds_read_b128 v[176:179], v5 offset:0
    ds_read_b128 v[180:183], v5 offset:16
    v_cmp_gt_f32 s[86:87], v240, v8
    s_add_u32 s54, s54, 17408
    s_cmp_eq_u32 s54, 69632
    s_cselect_b32 s54, 0, s54
    ds_read_b128 v[184:187], v5 offset:32
    ds_read_b128 v[188:191], v5 offset:48
    v_add_u32 v6, s54, v4
    ds_read_b128 v[192:195], v5 offset:64
    s_add_u32 s48, s48, 1
    ds_read_b128 v[196:199], v5 offset:80
    ds_read_b128 v[200:203], v5 offset:96
    ds_read_b128 v[204:207], v5 offset:112
    ds_write_b32 v14, v12
    s_or_b64 vcc, vcc, s[86:87]
    s_cbranch_vccnz L_ovf_i0
L_ovfdone_i0:
    v_add_f32 v7, v7, v8
    s_waitcnt lgkmcnt(0)
    s_mul_i32 s54, s55, 8704
    v_add_u32 v6, s54, v4
    s_cmp_eq_u32 s48, s49
    s_cbranch_scc1 L_ev_even
L_loop:
    s_waitcnt lgkmcnt(5)
    v_mfma_f32_32x32x16_bf16 v[112:127], v[176:179], v[16:19], v[160:175]
    ds_read_b32 v13, v11
    v_exp_f32 v252, v128
    v_exp_f32 v253, v129
    v_mfma_f32_32x32x16_bf16 v[112:127], v[180:183], v[20:23], v[112:127]
    v_exp_f32 v254, v130
    v_add_f32 v8, v252, v253
    v_cvt_pk_bf16_f32 v152, v252, v253
    v_exp_f32 v255, v131
    v_add_f32 v8, v8, v254
    v_mfma_f32_32x32x16_bf16 v[112:127], v[184:187], v[24:27], v[112:127]
    ds_read_b64_tr_b16 v[208:209], v6 offset:0
    ds_read_b64_tr_b16 v[210:211], v6 offset:256
    v_exp_f32 v252, v132
    v_add_f32 v8, v8, v255
    v_cvt_pk_bf16_f32 v153, v254, v255
    v_mfma_f32_32x32x16_bf16 v[112:127], v[188:191], v[28:31], v[112:127]
    ds_read_b64_tr_b16 v[212:213], v6 offset:64
    ds_read_b64_tr_b16 v[214:215], v6 offset:320
    v_exp_f32 v253, v133
    v_add_f32 v8, v8, v252
    v_exp_f32 v254, v134
    s_waitcnt lgkmcnt(6)
    v_mfma_f32_32x32x16_bf16 v[112:127], v[192:195], v[32:35], v[112:127]
    ds_read_b64_tr_b16 v[216:217], v6 offset:128
    ds_read_b64_tr_b16 v[218:219], v6 offset:384
    v_add_f32 v8, v8, v253
    v_cvt_pk_bf16_f32 v154, v252, v253
    v_exp_f32 v255, v135
    v_mfma_f32_32x32x16_bf16 v[112:127], v[196:199], v[36:39], v[112:127]
    ds_read_b64_tr_b16 v[220:221], v6 offset:192
    ds_read_b64_tr_b16 v[222:223], v6 offset:448
    v_add_f32 v8, v8, v254
    v_exp_f32 v252, v136
    v_add_f32 v8, v8, v255
    v_mfma_f32_32x32x16_bf16 v[112:127], v[200:203], v[40:43], v[112:127]
    ds_read_b64_tr_b16 v[224:225], v6 offset:512
    ds_read_b64_tr_b16 v[226:227], v6 offset:768
    v_cvt_pk_bf16_f32 v155, v254, v255
    v_exp_f32 v253, v137
    v_add_f32 v8, v8, v252
    v_mfma_f32_32x32x16_bf16 v[112:127], v[204:207], v[44:47], v[112:127]
    ds_read_b64_tr_b16 v[228:229], v6 offset:576
    ds_read_b64_tr_b16 v[230:231], v6 offset:832
    v_exp_f32 v254, v138
    v_add_f32 v8, v8, v253
    v_cvt_pk_bf16_f32 v156, v252, v253
    s_waitcnt lgkmcnt(4)
    v_mfma_f32_32x32x16_bf16 v[48:63], v[208:211], v[144:147], v[48:63]
    ds_read_b64_tr_b16 v[232:233], v6 offset:640
    ds_read_b64_tr_b16 v[234:235], v6 offset:896
    v_readfirstlane_b32 s52, v13
    v_exp_f32 v255, v139
    v_add_f32 v8, v8, v254
    v_mfma_f32_32x32x16_bf16 v[64:79], v[212:215], v[144:147], v[64:79]
    ds_read_b64_tr_b16 v[236:237], v6 offset:704
    ds_read_b64_tr_b16 v[238:239], v6 offset:960
    v_exp_f32 v252, v140
    v_add_f32 v8, v8, v255
    s_cmp_ge_u32 s52, s48
    s_cbranch_scc0 L_poll_odd
L_polldone_odd:
    v_mfma_f32_32x32x16_bf16 v[80:95], v[216:219], v[144:147], v[80:95]
    ds_read_b128 v[176:179], v5 offset:8320
    ds_read_b128 v[180:183], v5 offset:8336
    v_cvt_pk_bf16_f32 v157, v254, v255
    v_exp_f32 v253, v141
    v_add_f32 v8, v8, v252
    v_mfma_f32_32x32x16_bf16 v[96:111], v[220:223], v[144:147], v[96:111]
    ds_read_b128 v[184:187], v5 offset:8352
    ds_read_b128 v[188:191], v5 offset:8368
    v_exp_f32 v254, v142
    v_add_f32 v8, v8, v253
    v_cvt_pk_bf16_f32 v158, v252, v253
    s_waitcnt lgkmcnt(4)
    v_mfma_f32_32x32x16_bf16 v[48:63], v[224:227], v[148:151], v[48:63]
    ds_read_b128 v[192:195], v5 offset:8384
    v_exp_f32 v255, v143
    v_add_f32 v8, v8, v254
    v_add_u32 v12, 1, v12
    s_add_u32 s48, s48, 1
    v_mfma_f32_32x32x16_bf16 v[64:79], v[228:231], v[148:151], v[64:79]
    ds_read_b128 v[196:199], v5 offset:8400
    v_add_f32 v8, v8, v255
    v_cvt_pk_bf16_f32 v159, v254, v255
    s_add_u32 s53, s53, 16640
    s_cmp_eq_u32 s53, 66560
    s_cselect_b32 s53, 0, s53
    v_mfma_f32_32x32x16_bf16 v[80:95], v[232:235], v[148:151], v[80:95]
    ds_read_b128 v[200:203], v5 offset:8416
    v_cmp_lt_f32 vcc, 0x44800000, v8
    v_mfma_f32_32x32x16_bf16 v[96:111], v[236:239], v[148:151], v[96:111]
    ds_read_b128 v[204:207], v5 offset:8432
    ds_write_b32 v14, v12
    v_add_u32 v5, s53, v3
    s_cbranch_vccnz L_ovf_odd
L_ovfdone_odd:
    v_add_f32 v7, v7, v8
    s_cmp_eq_u32 s48, s49
    s_cbranch_scc1 L_ev_odd
L_loop_mid:
    s_waitcnt lgkmcnt(5)
    v_mfma_f32_32x32x16_bf16 v[128:143], v[176:179], v[16:19], v[160:175]
    ds_read_b32 v13, v11
    v_exp_f32 v252, v112
    v_exp_f32 v253, v113
    v_mfma_f32_32x32x16_bf16 v[128:143], v[180:183], v[20:23], v[128:143]
    v_exp_f32 v254, v114
    v_add_f32 v8, v252, v253
    v_cvt_pk_bf16_f32 v144, v252, v253
    v_exp_f32 v255, v115
    v_add_f32 v8, v8, v254
    v_mfma_f32_32x32x16_bf16 v[128:143], v[184:187], v[24:27], v[128:143]
    ds_read_b64_tr_b16 v[208:209], v6 offset:8704
    ds_read_b64_tr_b16 v[210:211], v6 offset:8960
    v_exp_f32 v252, v116
    v_add_f32 v8, v8, v255
    v_cvt_pk_bf16_f32 v145, v254, v255
    v_mfma_f32_32x32x16_bf16 v[128:143], v[188:191], v[28:31], v[128:143]
    ds_read_b64_tr_b16 v[212:213], v6 offset:8768
    ds_read_b64_tr_b16 v[214:215], v6 offset:9024
    v_exp_f32 v253, v117
    v_add_f32 v8, v8, v252
    v_exp_f32 v254, v118
    s_waitcnt lgkmcnt(6)
    v_mfma_f32_32x32x16_bf16 v[128:143], v[192:195], v[32:35], v[128:143]
    ds_read_b64_tr_b16 v[216:217], v6 offset:8832
    ds_read_b64_tr_b16 v[218:219], v6 offset:9088
    v_add_f32 v8, v8, v253
    v_cvt_pk_bf16_f32 v146, v252, v253
    v_exp_f32 v255, v119
    v_mfma_f32_32x32x16_bf16 v[128:143], v[196:199], v[36:39], v[128:143]
    ds_read_b64_tr_b16 v[220:221], v6 offset:8896
    ds_read_b64_tr_b16 v[222:223], v6 offset:9152
    v_add_f32 v8, v8, v254
    v_exp_f32 v252, v120
    v_add_f32 v8, v8, v255
    v_mfma_f32_32x32x16_bf16 v[128:143], v[200:203], v[40:43], v[128:143]
    ds_read_b64_tr_b16 v[224:225], v6 offset:9216
    ds_read_b64_tr_b16 v[226:227], v6 offset:9472
    v_cvt_pk_bf16_f32 v147, v254, v255
    v_exp_f32 v253, v121
    v_add_f32 v8, v8, v252
    v_mfma_f32_32x32x16_bf16 v[128:143], v[204:207], v[44:47], v[128:143]
    ds_read_b64_tr_b16 v[228:229], v6 offset:9280
    ds_read_b64_tr_b16 v[230:231], v6 offset:9536
    v_exp_f32 v254, v122
    v_add_f32 v8, v8, v253
    v_cvt_pk_bf16_f32 v148, v252, v253
    s_waitcnt lgkmcnt(4)
    v_mfma_f32_32x32x16_bf16 v[48:63], v[208:211], v[152:155], v[48:63]
    ds_read_b64_tr_b16 v[232:233], v6 offset:9344
    ds_read_b64_tr_b16 v[234:235], v6 offset:9600
    v_readfirstlane_b32 s52, v13
    v_exp_f32 v255, v123
    v_add_f32 v8, v8, v254
    v_mfma_f32_32x32x16_bf16 v[64:79], v[212:215], v[152:155], v[64:79]
    ds_read_b64_tr_b16 v[236:237], v6 offset:9408
    ds_read_b64_tr_b16 v[238:239], v6 offset:9664
    v_exp_f32 v252, v124
    v_add_f32 v8, v8, v255
    s_cmp_ge_u32 s52, s48
    s_cbranch_scc0 L_poll_even
L_polldone_even:
    v_mfma_f32_32x32x16_bf16 v[80:95], v[216:219], v[152:155], v[80:95]
    ds_read_b128 v[176:179], v5 offset:0
    ds_read_b128 v[180:183], v5 offset:16
    v_cvt_pk_bf16_f32 v149, v254, v255
    s_add_u32 s54, s54, 17408
    s_cmp_eq_u32 s54, 69632
    s_cselect_b32 s54, 0, s54
    v_mfma_f32_32x32x16_bf16 v[96:111], v[220:223], v[152:155], v[96:111]
    ds_read_b128 v[184:187], v5 offset:32
    ds_read_b128 v[188:191], v5 offset:48
    v_exp_f32 v253, v125
    v_add_f32 v8, v8, v252
    v_add_u32 v6, s54, v4
    s_waitcnt lgkmcnt(4)
    v_mfma_f32_32x32x16_bf16 v[48:63], v[224:227], v[156:159], v[48:63]
    ds_read_b128 v[192:195], v5 offset:64
    v_exp_f32 v254, v126
    v_add_f32 v8, v8, v253
    v_cvt_pk_bf16_f32 v150, v252, v253
    s_add_u32 s48, s48, 1
    v_mfma_f32_32x32x16_bf16 v[64:79], v[228:231], v[156:159], v[64:79]
    ds_read_b128 v[196:199], v5 offset:80
    v_exp_f32 v255, v127
    v_add_f32 v8, v8, v254
    v_add_u32 v12, 1, v12
    v_add_f32 v8, v8, v255
    v_mfma_f32_32x32x16_bf16 v[80:95], v[232:235], v[156:159], v[80:95]
    ds_read_b128 v[200:203], v5 offset:96
    v_cvt_pk_bf16_f32 v151, v254, v255
    v_cmp_lt_f32 vcc, 0x44800000, v8
    v_mfma_f32_32x32x16_bf16 v[96:111], v[236:239], v[156:159], v[96:111]
    ds_read_b128 v[204:207], v5 offset:112
    ds_write_b32 v14, v12
    s_cbranch_vccnz L_ovf_even
L_ovfdone_even:
    v_add_f32 v7, v7, v8
    s_cmp_lg_u32 s48, s49
    s_cbranch_scc1 L_loop
    s_branch L_ev_even
L_fin_even:
    s_waitcnt lgkmcnt(0)
    ds_read_b64_tr_b16 v[208:209], v6 offset:0
    ds_read_b64_tr_b16 v[210:211], v6 offset:256
    ds_read_b64_tr_b16 v[212:213], v6 offset:64
    ds_read_b64_tr_b16 v[214:215], v6 offset:320
    ds_read_b64_tr_b16 v[216:217], v6 offset:128
    ds_read_b64_tr_b16 v[218:219], v6 offset:384
    ds_read_b64_tr_b16 v[220:221], v6 offset:192
    ds_read_b64_tr_b16 v[222:223], v6 offset:448
    ds_read_b64_tr_b16 v[224:225], v6 offset:512
    ds_read_b64_tr_b16 v[226:227], v6 offset:768
    ds_read_b64_tr_b16 v[228:229], v6 offset:576
    ds_read_b64_tr_b16 v[230:231], v6 offset:832
    ds_read_b64_tr_b16 v[232:233], v6 offset:640
    ds_read_b64_tr_b16 v[234:235], v6 offset:896
    s_waitcnt lgkmcnt(12)
    v_mfma_f32_32x32x16_bf16 v[48:63], v[208:211], v[144:147], v[48:63]
    ds_read_b64_tr_b16 v[236:237], v6 offset:704
    ds_read_b64_tr_b16 v[238:239], v6 offset:960
    s_waitcnt lgkmcnt(12)
    v_mfma_f32_32x32x16_bf16 v[64:79], v[212:215], v[144:147], v[64:79]
    s_waitcnt lgkmcnt(10)
    v_mfma_f32_32x32x16_bf16 v[80:95], v[216:219], v[144:147], v[80:95]
    s_waitcnt lgkmcnt(8)
    v_mfma_f32_32x32x16_bf16 v[96:111], v[220:223], v[144:147], v[96:111]
    s_waitcnt lgkmcnt(6)
    v_mfma_f32_32x32x16_bf16 v[48:63], v[224:227], v[148:151], v[48:63]
    s_waitcnt lgkmcnt(4)
    v_mfma_f32_32x32x16_bf16 v[64:79], v[228:231], v[148:151], v[64:79]
    s_waitcnt lgkmcnt(2)
    v_mfma_f32_32x32x16_bf16 v[80:95], v[232:235], v[148:151], v[80:95]
    s_waitcnt lgkmcnt(0)
    v_mfma_f32_32x32x16_bf16 v[96:111], v[236:239], v[148:151], v[96:111]
    s_branch L_epi
L_fin_odd:
    s_waitcnt lgkmcnt(0)
    ds_read_b64_tr_b16 v[208:209], v6 offset:8704
    ds_read_b64_tr_b16 v[210:211], v6 offset:8960
    ds_read_b64_tr_b16 v[212:213], v6 offset:8768
    ds_read_b64_tr_b16 v[214:215], v6 offset:9024
    ds_read_b64_tr_b16 v[216:217], v6 offset:8832
    ds_read_b64_tr_b16 v[218:219], v6 offset:9088
    ds_read_b64_tr_b16 v[220:221], v6 offset:8896
    ds_read_b64_tr_b16 v[222:223], v6 offset:9152
    ds_read_b64_tr_b16 v[224:225], v6 offset:9216
    ds_read_b64_tr_b16 v[226:227], v6 offset:9472
    ds_read_b64_tr_b16 v[228:229], v6 offset:9280
    ds_read_b64_tr_b16 v[230:231], v6 offset:9536
    ds_read_b64_tr_b16 v[232:233], v6 offset:9344
    ds_read_b64_tr_b16 v[234:235], v6 offset:9600
    s_waitcnt lgkmcnt(12)
    v_mfma_f32_32x32x16_bf16 v[48:63], v[208:211], v[152:155], v[48:63]
    ds_read_b64_tr_b16 v[236:237], v6 offset:9408
    ds_read_b64_tr_b16 v[238:239], v6 offset:9664
    s_waitcnt lgkmcnt(12)
    v_mfma_f32_32x32x16_bf16 v[64:79], v[212:215], v[152:155], v[64:79]
    s_waitcnt lgkmcnt(10)
    v_mfma_f32_32x32x16_bf16 v[80:95], v[216:219], v[152:155], v[80:95]
    s_waitcnt lgkmcnt(8)
    v_mfma_f32_32x32x16_bf16 v[96:111], v[220:223], v[152:155], v[96:111]
    s_waitcnt lgkmcnt(6)
    v_mfma_f32_32x32x16_bf16 v[48:63], v[224:227], v[156:159], v[48:63]
    s_waitcnt lgkmcnt(4)
    v_mfma_f32_32x32x16_bf16 v[64:79], v[228:231], v[156:159], v[64:79]
    s_waitcnt lgkmcnt(2)
    v_mfma_f32_32x32x16_bf16 v[80:95], v[232:235], v[156:159], v[80:95]
    s_waitcnt lgkmcnt(0)
    v_mfma_f32_32x32x16_bf16 v[96:111], v[236:239], v[156:159], v[96:111]
L_epi:
    v_mov_b32 v241, v7
    s_nop 1
    v_permlane32_swap_b32 v7, v241
    v_add_f32 v7, v7, v241
    v_rcp_f32 v242, v7
    s_mul_i32 s43, s39, 2560
    s_add_u32 s43, s43, 136192
    v_and_b32 v240, 31, v1
    v_mul_u32_u24 v248, 80, v240
    v_lshl_add_u32 v248, v2, 3, v248
    v_add_u32 v248, s43, v248
    v_lshrrev_b32 v240, 2, v1
    v_and_b32 v241, 3, v1
    v_mul_u32_u24 v249, 80, v240
    v_lshl_add_u32 v249, v241, 4, v249
    v_add_u32 v249, s43, v249
    v_lshlrev_b32 v250, 12, v240
    v_lshl_add_u32 v250, v241, 4, v250
    s_mov_b32 s44, 65536
    s_nop 3
    v_mul_f32 v48, v242, v48
    v_mul_f32 v49, v242, v49
    v_mul_f32 v50, v242, v50
    v_mul_f32 v51, v242, v51
    v_mul_f32 v52, v242, v52
    v_mul_f32 v53, v242, v53
    v_mul_f32 v54, v242, v54
    v_mul_f32 v55, v242, v55
    v_mul_f32 v56, v242, v56
    v_mul_f32 v57, v242, v57
    v_mul_f32 v58, v242, v58
    v_mul_f32 v59, v242, v59
    v_mul_f32 v60, v242, v60
    v_mul_f32 v61, v242, v61
    v_mul_f32 v62, v242, v62
    v_mul_f32 v63, v242, v63
    v_cvt_pk_bf16_f32 v176, v48, v49
    v_cvt_pk_bf16_f32 v177, v50, v51
    v_cvt_pk_bf16_f32 v178, v52, v53
    v_cvt_pk_bf16_f32 v179, v54, v55
    v_cvt_pk_bf16_f32 v180, v56, v57
    v_cvt_pk_bf16_f32 v181, v58, v59
    v_cvt_pk_bf16_f32 v182, v60, v61
    v_cvt_pk_bf16_f32 v183, v62, v63
    ds_write_b128 v248, v[176:179]
    ds_write_b128 v248, v[180:183] offset:16
    s_waitcnt lgkmcnt(0)
    ds_read_b128 v[208:211], v249
    ds_read_b128 v[212:215], v249 offset:1280
    v_mul_f32 v64, v242, v64
    v_mul_f32 v65, v242, v65
    v_mul_f32 v66, v242, v66
    v_mul_f32 v67, v242, v67
    v_mul_f32 v68, v242, v68
    v_mul_f32 v69, v242, v69
    v_mul_f32 v70, v242, v70
    v_mul_f32 v71, v242, v71
    v_mul_f32 v72, v242, v72
    v_mul_f32 v73, v242, v73
    v_mul_f32 v74, v242, v74
    v_mul_f32 v75, v242, v75
    v_mul_f32 v76, v242, v76
    v_mul_f32 v77, v242, v77
    v_mul_f32 v78, v242, v78
    v_mul_f32 v79, v242, v79
    v_cvt_pk_bf16_f32 v184, v64, v65
    v_cvt_pk_bf16_f32 v185, v66, v67
    v_cvt_pk_bf16_f32 v186, v68, v69
    v_cvt_pk_bf16_f32 v187, v70, v71
    v_cvt_pk_bf16_f32 v188, v72, v73
    v_cvt_pk_bf16_f32 v189, v74, v75
    v_cvt_pk_bf16_f32 v190, v76, v77
    v_cvt_pk_bf16_f32 v191, v78, v79
    s_waitcnt lgkmcnt(0)
    buffer_store_dwordx4 v[208:211], v250, s[28:31], 0 offen offset:0 sc1
    buffer_store_dwordx4 v[212:215], v250, s[28:31], s44 offen offset:0 sc1
    ds_write_b128 v248, v[184:187]
    ds_write_b128 v248, v[188:191] offset:16
    s_waitcnt lgkmcnt(0)
    ds_read_b128 v[216:219], v249
    ds_read_b128 v[220:223], v249 offset:1280
    v_mul_f32 v80, v242, v80
    v_mul_f32 v81, v242, v81
    v_mul_f32 v82, v242, v82
    v_mul_f32 v83, v242, v83
    v_mul_f32 v84, v242, v84
    v_mul_f32 v85, v242, v85
    v_mul_f32 v86, v242, v86
    v_mul_f32 v87, v242, v87
    v_mul_f32 v88, v242, v88
    v_mul_f32 v89, v242, v89
    v_mul_f32 v90, v242, v90
    v_mul_f32 v91, v242, v91
    v_mul_f32 v92, v242, v92
    v_mul_f32 v93, v242, v93
    v_mul_f32 v94, v242, v94
    v_mul_f32 v95, v242, v95
    v_cvt_pk_bf16_f32 v192, v80, v81
    v_cvt_pk_bf16_f32 v193, v82, v83
    v_cvt_pk_bf16_f32 v194, v84, v85
    v_cvt_pk_bf16_f32 v195, v86, v87
    v_cvt_pk_bf16_f32 v196, v88, v89
    v_cvt_pk_bf16_f32 v197, v90, v91
    v_cvt_pk_bf16_f32 v198, v92, v93
    v_cvt_pk_bf16_f32 v199, v94, v95
    s_waitcnt lgkmcnt(0)
    buffer_store_dwordx4 v[216:219], v250, s[28:31], 0 offen offset:64 sc1
    buffer_store_dwordx4 v[220:223], v250, s[28:31], s44 offen offset:64 sc1
    ds_write_b128 v248, v[192:195]
    ds_write_b128 v248, v[196:199] offset:16
    s_waitcnt lgkmcnt(0)
    ds_read_b128 v[224:227], v249
    ds_read_b128 v[228:231], v249 offset:1280
    v_mul_f32 v96, v242, v96
    v_mul_f32 v97, v242, v97
    v_mul_f32 v98, v242, v98
    v_mul_f32 v99, v242, v99
    v_mul_f32 v100, v242, v100
    v_mul_f32 v101, v242, v101
    v_mul_f32 v102, v242, v102
    v_mul_f32 v103, v242, v103
    v_mul_f32 v104, v242, v104
    v_mul_f32 v105, v242, v105
    v_mul_f32 v106, v242, v106
    v_mul_f32 v107, v242, v107
    v_mul_f32 v108, v242, v108
    v_mul_f32 v109, v242, v109
    v_mul_f32 v110, v242, v110
    v_mul_f32 v111, v242, v111
    v_cvt_pk_bf16_f32 v200, v96, v97
    v_cvt_pk_bf16_f32 v201, v98, v99
    v_cvt_pk_bf16_f32 v202, v100, v101
    v_cvt_pk_bf16_f32 v203, v102, v103
    v_cvt_pk_bf16_f32 v204, v104, v105
    v_cvt_pk_bf16_f32 v205, v106, v107
    v_cvt_pk_bf16_f32 v206, v108, v109
    v_cvt_pk_bf16_f32 v207, v110, v111
    s_waitcnt lgkmcnt(0)
    buffer_store_dwordx4 v[224:227], v250, s[28:31], 0 offen offset:128 sc1
    buffer_store_dwordx4 v[228:231], v250, s[28:31], s44 offen offset:128 sc1
    ds_write_b128 v248, v[200:203]
    ds_write_b128 v248, v[204:207] offset:16
    s_waitcnt lgkmcnt(0)
    ds_read_b128 v[232:235], v249
    ds_read_b128 v[236:239], v249 offset:1280
    s_waitcnt lgkmcnt(0)
    buffer_store_dwordx4 v[232:235], v250, s[28:31], 0 offen offset:192 sc1
    buffer_store_dwordx4 v[236:239], v250, s[28:31], s44 offen offset:192 sc1
L_exit:
L_end:
    s_endpgm
L_idle:
    v_mov_b32 v12, 0x7fffffff
    ds_write_b32 v14, v12
    s_lshl_b32 s43, s38, 4
    s_add_u32 s43, s43, s39
    s_cmp_eq_u32 s43, 5
    s_cbranch_scc0 L_exit
    s_mov_b32 s56, 0x82576c
    s_mov_b32 s57, 0x6500c0
    s_mov_b32 s58, 0xfff160
    s_cmp_eq_u32 s46, 4
    s_cselect_b32 s56, 0x8078c, s56
    s_cselect_b32 s57, 0x7462c4, s57
    s_cselect_b32 s58, 0xfff364, s58
    s_cmp_eq_u32 s46, 5
    s_cselect_b32 s56, 0x284040, s56
    s_cselect_b32 s57, 0x885484, s57
    s_cselect_b32 s58, 0xfff524, s58
    s_cmp_eq_u32 s46, 6
    s_cselect_b32 s56, 0x444244, s56
    s_cselect_b32 s57, 0x1200e0, s57
    s_cselect_b32 s58, 0xfff180, s58
    s_cmp_eq_u32 s46, 7
    s_cselect_b32 s56, 0xa0404, s56
    s_cselect_b32 s57, 0x3242e4, s57
    s_cselect_b32 s58, 0xfff384, s58
    s_cmp_eq_u32 s46, 8
    s_cselect_b32 s56, 0x2a4060, s56
    s_cselect_b32 s57, 0x4e44a4, s57
    s_cselect_b32 s58, 0xfff544, s58
    s_cmp_eq_u32 s46, 9
    s_cselect_b32 s56, 0x464264, s56
    s_cselect_b32 s57, 0x140630, s57
    s_cselect_b32 s58, 0xfff690, s58
    s_cmp_eq_u32 s46, 10
    s_cselect_b32 s56, 0x1f0424, s56
    s_cselect_b32 s57, 0x344726, s57
    s_cselect_b32 s58, 0xfff8c5, s58
    s_cmp_eq_u32 s46, 11
    s_cselect_b32 s56, 0x6101d0, s56
    s_cselect_b32 s57, 0x504865, s57
    s_cselect_b32 s58, 0xfff3a4, s58
    s_cmp_eq_u32 s46, 12
    s_cselect_b32 s56, 0x7065f0, s56
    s_cselect_b32 s57, 0x670100, s57
    s_cselect_b32 s58, 0xfff564, s58
    s_cmp_eq_u32 s46, 13
    s_cselect_b32 s56, 0x7cc6e6, s56
    s_cselect_b32 s57, 0x766304, s57
    s_cselect_b32 s58, 0xfff584, s58
    s_cmp_eq_u32 s46, 14
    s_cselect_b32 s56, 0x8457ac, s56
    s_cselect_b32 s57, 0x8a54c4, s57
    s_cselect_b32 s58, 0xfff5a4, s58
    s_add_u32 s20, s6, s40
    s_addc_u32 s21, s7, 0
    s_add_u32 s24, s8, s40
    s_addc_u32 s25, s9, 0
    s_mov_b32 s22, 9277696
    s_mov_b32 s26, 9277696
    s_mov_b32 s23, 0x00020000
    s_mov_b32 s27, 0x00020000
    v_lshrrev_b32 v240, 1, v1
    v_and_b32 v241, 1, v1
    v_lshlrev_b32 v240, 12, v240
    v_lshl_add_u32 v240, v241, 7, v240
L_pf_wait:
    ds_read_b32 v13, v11
    s_waitcnt lgkmcnt(0)
    v_readfirstlane_b32 s52, v13
    s_cmp_ge_u32 s52, 2
    s_cbranch_scc1 L_pf_go
    s_sleep 2
    s_branch L_pf_wait
L_pf_go:
    s_and_b32 s43, s56, 0xfff
    s_lshl_b32 s43, s43, 12
    buffer_load_dword v242, v240, s[20:23], s43 offen
    buffer_load_dword v243, v240, s[24:27], s43 offen
    s_bfe_u32 s43, s56, 0xc000c
    s_lshl_b32 s43, s43, 12
    buffer_load_dword v242, v240, s[20:23], s43 offen
    buffer_load_dword v243, v240, s[24:27], s43 offen
    s_and_b32 s43, s57, 0xfff
    s_lshl_b32 s43, s43, 12
    s_waitcnt vmcnt(2)
    buffer_load_dword v242, v240, s[20:23], s43 offen
    buffer_load_dword v243, v240, s[24:27], s43 offen
    s_bfe_u32 s43, s57, 0xc000c
    s_lshl_b32 s43, s43, 12
    s_waitcnt vmcnt(2)
    buffer_load_dword v242, v240, s[20:23], s43 offen
    buffer_load_dword v243, v240, s[24:27], s43 offen
    s_and_b32 s43, s58, 0xfff
    s_lshl_b32 s43, s43, 12
    s_waitcnt vmcnt(2)
    buffer_load_dword v242, v240, s[20:23], s43 offen
    buffer_load_dword v243, v240, s[24:27], s43 offen
    s_bfe_u32 s43, s58, 0xc000c
    s_lshl_b32 s43, s43, 12
    s_waitcnt vmcnt(2)
    buffer_load_dword v242, v240, s[20:23], s43 offen
    buffer_load_dword v243, v240, s[24:27], s43 offen
    s_branch L_exit
L_loader:
    v_mov_b32 v187, 156688
    v_add_u32 v192, 0, v5
    v_add_u32 v200, 0, v6
    v_add_u32 v193, 3056, v5
    v_add_u32 v201, 3008, v6
    v_add_u32 v194, 6112, v5
    v_add_u32 v202, 6016, v6
    v_add_u32 v195, 9168, v5
    v_add_u32 v203, 9024, v6
    v_add_u32 v196, 16384, v5
    v_add_u32 v204, 16384, v6
    v_add_u32 v197, 19440, v5
    v_add_u32 v205, 19392, v6
    v_add_u32 v198, 22496, v5
    v_add_u32 v206, 22400, v6
    v_add_u32 v199, 25552, v5
    v_add_u32 v207, 25408, v6
    s_add_u32 s20, s6, s40
    s_addc_u32 s21, s7, 0
    s_add_u32 s24, s8, s40
    s_addc_u32 s25, s9, 0
    s_lshl_b32 s70, s35, 12
    s_sub_u32 s70, s70, 3840
    s_mov_b32 s71, 8274176
    s_mov_b32 s22, s70
    s_mov_b32 s26, s70
    s_mov_b32 s23, 0x00020000
    s_mov_b32 s27, 0x00020000
    s_lshl_b32 s68, s34, 12
    s_lshl_b32 s43, s37, 17
    s_add_u32 s57, s68, s43
    s_mov_b32 s58, s57
    s_lshl_b32 s43, s36, 17
    s_add_u32 s67, s68, s43
    s_cmp_eq_u32 s38, 2
    s_cselect_b32 s67, 2162688, s67
    s_cselect_b32 s68, 7782400, s68
    s_cselect_b32 s71, s71, s70
    s_mov_b32 s59, 0
    s_mov_b32 s60, 66560
    s_mov_b32 s56, 0
    s_mov_b32 s61, 0
    s_mov_b32 s63, 0
    s_mov_b32 s64, 0
    s_mov_b32 s62, 0
    s_mov_b32 s66, 0
    s_lshl_b32 s65, s36, 1
    s_mov_b32 m0, s59
    s_add_u32 s69, s59, 4160
    buffer_load_dwordx4 v192, s[20:23], s57 offen offset:0  lds
    buffer_load_dwordx4 v193, s[20:23], s57 offen offset:1040  lds
    buffer_load_dwordx4 v194, s[20:23], s57 offen offset:2080  lds
    buffer_load_dwordx4 v195, s[20:23], s57 offen offset:3120  lds
    s_mov_b32 m0, s69
    s_add_u32 s59, s59, 8320
    buffer_load_dwordx4 v196, s[20:23], s57 offen offset:0  lds
    buffer_load_dwordx4 v197, s[20:23], s57 offen offset:1040  lds
    buffer_load_dwordx4 v198, s[20:23], s57 offen offset:2080  lds
    buffer_load_dwordx4 v199, s[20:23], s57 offen offset:3120  lds
    s_add_u32 s57, s57, 131072
    s_cmp_eq_u32 s57, s67
    s_cselect_b32 s57, s68, s57
    s_cselect_b32 s22, s71, s22
    s_cmp_eq_u32 s59, 66560
    s_cselect_b32 s59, 0, s59
    s_add_u32 s63, s63, 1
    s_add_u32 s56, s56, 1
    s_mov_b32 m0, s59
    s_add_u32 s69, s59, 4160
    buffer_load_dwordx4 v192, s[20:23], s57 offen offset:0  lds
    buffer_load_dwordx4 v193, s[20:23], s57 offen offset:1040  lds
    buffer_load_dwordx4 v194, s[20:23], s57 offen offset:2080  lds
    buffer_load_dwordx4 v195, s[20:23], s57 offen offset:3120  lds
    s_mov_b32 m0, s69
    s_add_u32 s59, s59, 8320
    buffer_load_dwordx4 v196, s[20:23], s57 offen offset:0  lds
    buffer_load_dwordx4 v197, s[20:23], s57 offen offset:1040  lds
    buffer_load_dwordx4 v198, s[20:23], s57 offen offset:2080  lds
    buffer_load_dwordx4 v199, s[20:23], s57 offen offset:3120  lds
    s_add_u32 s57, s57, 131072
    s_cmp_eq_u32 s57, s67
    s_cselect_b32 s57, s68, s57
    s_cselect_b32 s22, s71, s22
    s_cmp_eq_u32 s59, 66560
    s_cselect_b32 s59, 0, s59
    s_add_u32 s63, s63, 1
    s_add_u32 s56, s56, 1
    v_and_b32 v247, 7, v244
    v_mul_u32_u24 v3, 1040, v247
    v_lshrrev_b32 v247, 3, v244
    v_lshl_add_u32 v3, v247, 8, v3
    v_and_b32 v247, 1, v247
    v_xor_b32 v247, v247, v245
    v_lshl_add_u32 v3, v247, 7, v3
    v_add_u32 v246, s73, v3
    s_cmp_lt_u32 s41, s42
    s_cselect_b32 s72, 1, 0
    s_cbranch_scc1 L_ld_top
    v_mov_b32 v12, 0x7fffffff
    ds_write_b32 v14, v12
L_ld_top:
    s_getreg_b32 s43, hwreg(HW_REG_IB_STS)
    s_and_b32 s44, s43, 15
    s_bfe_u32 s43, s43, 0x20016
    s_lshl_b32 s43, s43, 4
    s_add_u32 s44, s44, s43
    s_add_u32 s44, s44, 7
    s_lshr_b32 s44, s44, 3
    s_sub_u32 s43, s56, s44
    s_cmp_eq_u32 s43, s61
    s_cbranch_scc1 L_ld_nopost
    s_mov_b32 s61, s43
    s_sub_i32 s45, s43, 2
    s_ashr_i32 s45, s45, 1
    s_sub_i32 s69, s43, s36
    s_max_i32 s45, s45, s69
    s_add_u32 s45, s45, 3
    s_cmp_le_u32 s43, 3
    s_cselect_b32 s45, s43, s45
    v_mov_b32 v184, s45
    ds_write_b32 v11, v184
    s_cmp_eq_u32 s61, s65
    s_cbranch_scc1 L_compute
L_ld_nopost:
    s_cmp_ge_u32 s44, 5
    s_cbranch_scc1 L_ld_sleep
    s_cmp_ge_u32 s56, s65
    s_cbranch_scc1 L_ld_sleep
    s_add_u32 s43, s64, 3
    s_min_u32 s43, s43, s36
    s_cmp_lt_u32 s63, s43
    s_cbranch_scc0 L_ld_V
    s_sub_i32 s45, s63, 7
    s_max_i32 s45, s45, 1
    s_cmp_eq_u32 s63, 8
    s_cselect_b32 s45, 2, s45
    s_cmp_lt_u32 s63, 4
    s_cselect_b32 s45, 0, s45
    s_cmp_ge_i32 s62, s45
    s_cbranch_scc0 L_ld_poll
    s_mov_b32 m0, s59
    s_add_u32 s69, s59, 4160
    buffer_load_dwordx4 v192, s[20:23], s57 offen offset:0  lds
    buffer_load_dwordx4 v193, s[20:23], s57 offen offset:1040  lds
    buffer_load_dwordx4 v194, s[20:23], s57 offen offset:2080  lds
    buffer_load_dwordx4 v195, s[20:23], s57 offen offset:3120  lds
    s_mov_b32 m0, s69
    s_add_u32 s59, s59, 8320
    buffer_load_dwordx4 v196, s[20:23], s57 offen offset:0  lds
    buffer_load_dwordx4 v197, s[20:23], s57 offen offset:1040  lds
    buffer_load_dwordx4 v198, s[20:23], s57 offen offset:2080  lds
    buffer_load_dwordx4 v199, s[20:23], s57 offen offset:3120  lds
    s_add_u32 s57, s57, 131072
    s_cmp_eq_u32 s57, s67
    s_cselect_b32 s57, s68, s57
    s_cselect_b32 s22, s71, s22
    s_cmp_eq_u32 s59, 66560
    s_cselect_b32 s59, 0, s59
    s_add_u32 s63, s63, 1
    s_add_u32 s56, s56, 1
    s_branch L_ld_top
L_ld_V:
    s_sub_i32 s45, s64, 5
    s_cmp_lt_u32 s64, 8
    s_cselect_b32 s45, 1, s45
    s_cmp_lt_u32 s64, 4
    s_cselect_b32 s45, 0, s45
    s_cmp_ge_i32 s66, s45
    s_cbranch_scc0 L_ld_poll
    s_mov_b32 m0, s60
    s_add_u32 s69, s60, 4352
    buffer_load_dwordx4 v200, s[24:27], s58 offen offset:0  lds
    buffer_load_dwordx4 v201, s[24:27], s58 offen offset:1088  lds
    buffer_load_dwordx4 v202, s[24:27], s58 offen offset:2176  lds
    buffer_load_dwordx4 v203, s[24:27], s58 offen offset:3264  lds
    s_mov_b32 m0, s69
    s_add_u32 s60, s60, 8704
    buffer_load_dwordx4 v204, s[24:27], s58 offen offset:0  lds
    buffer_load_dwordx4 v205, s[24:27], s58 offen offset:1088  lds
    buffer_load_dwordx4 v206, s[24:27], s58 offen offset:2176  lds
    buffer_load_dwordx4 v207, s[24:27], s58 offen offset:3264  lds
    s_add_u32 s58, s58, 131072
    s_cmp_eq_u32 s58, s67
    s_cselect_b32 s58, s68, s58
    s_cselect_b32 s26, s71, s26
    s_cmp_eq_u32 s60, 136192
    s_cselect_b32 s60, 66560, s60
    s_add_u32 s64, s64, 1
    s_add_u32 s56, s56, 1
    s_branch L_ld_top
L_ld_poll:
    ds_read_b128 v[180:183], v187
    ds_read_b128 v[188:191], v187 offset:16
    s_waitcnt lgkmcnt(0)
    v_min3_u32 v180, v180, v181, v182
    v_min3_u32 v188, v188, v189, v190
    v_min_u32 v180, v180, v183
    v_min3_u32 v188, v188, v191, v180
    v_readfirstlane_b32 s43, v180
    v_readfirstlane_b32 s44, v188
    s_min_u32 s45, s43, s72
    s_cmp_eq_u32 s45, 0
    s_cbranch_scc1 L_ld_noqf
    ds_read_b128 v[16:19], v246 offset:0
    ds_read_b128 v[20:23], v246 offset:16
    ds_read_b128 v[24:27], v246 offset:32
    ds_read_b128 v[28:31], v246 offset:48
    ds_read_b128 v[32:35], v246 offset:64
    ds_read_b128 v[36:39], v246 offset:80
    ds_read_b128 v[40:43], v246 offset:96
    ds_read_b128 v[44:47], v246 offset:112
    v_mov_b32 v12, 1
    s_waitcnt lgkmcnt(0)
    ds_write_b32 v14, v12
    s_mov_b32 s72, 0
L_ld_noqf:
    s_add_u32 s45, s62, s66
    s_mov_b32 s62, s43
    s_mov_b32 s66, s44
    s_add_u32 s43, s43, s44
    s_cmp_lg_u32 s43, s45
    s_cbranch_scc1 L_ld_top
    s_sleep 2
L_ld_sleep:
    s_sleep 1
    s_branch L_ld_top
L_mask_pre:
    s_mov_b32 s49, s47
    v_sub_u32 v240, s50, v2
    v_cmp_lt_i32 s[86:87], 0, v240
    v_cmp_lt_i32 s[88:89], 1, v240
    v_cmp_lt_i32 s[90:91], 2, v240
    v_cmp_lt_i32 s[92:93], 3, v240
    v_cndmask_b32 v112, v10, v112, s[86:87]
    v_cndmask_b32 v113, v10, v113, s[88:89]
    v_cndmask_b32 v114, v10, v114, s[90:91]
    v_cndmask_b32 v115, v10, v115, s[92:93]
    v_cmp_lt_i32 s[86:87], 8, v240
    v_cmp_lt_i32 s[88:89], 9, v240
    v_cmp_lt_i32 s[90:91], 10, v240
    v_cmp_lt_i32 s[92:93], 11, v240
    v_cndmask_b32 v116, v10, v116, s[86:87]
    v_cndmask_b32 v117, v10, v117, s[88:89]
    v_cndmask_b32 v118, v10, v118, s[90:91]
    v_cndmask_b32 v119, v10, v119, s[92:93]
    v_cmp_lt_i32 s[86:87], 16, v240
    v_cmp_lt_i32 s[88:89], 17, v240
    v_cmp_lt_i32 s[90:91], 18, v240
    v_cmp_lt_i32 s[92:93], 19, v240
    v_cndmask_b32 v120, v10, v120, s[86:87]
    v_cndmask_b32 v121, v10, v121, s[88:89]
    v_cndmask_b32 v122, v10, v122, s[90:91]
    v_cndmask_b32 v123, v10, v123, s[92:93]
    v_cmp_lt_i32 s[86:87], 24, v240
    v_cmp_lt_i32 s[88:89], 25, v240
    v_cmp_lt_i32 s[90:91], 26, v240
    v_cmp_lt_i32 s[92:93], 27, v240
    v_cndmask_b32 v124, v10, v124, s[86:87]
    v_cndmask_b32 v125, v10, v125, s[88:89]
    v_cndmask_b32 v126, v10, v126, s[90:91]
    v_cndmask_b32 v127, v10, v127, s[92:93]
    s_branch L_maskdone_pre
L_poll_i0:
    ds_read_b32 v13, v11
    s_waitcnt lgkmcnt(0)
    v_readfirstlane_b32 s52, v13
    s_cmp_ge_u32 s52, s48
    s_cbranch_scc1 L_polldone_i0
    s_sleep 1
    s_branch L_poll_i0
L_ovf_i0:
    s_nop 7
    s_nop 7
    v_max3_f32 v240, v112, v113, v114
    v_max3_f32 v241, v115, v116, v117
    v_max3_f32 v242, v118, v119, v120
    v_max3_f32 v243, v121, v122, v123
    v_max3_f32 v244, v124, v125, v126
    v_max3_f32 v240, v240, v241, v127
    v_max3_f32 v242, v242, v243, v244
    v_max_f32 v240, v240, v242
    v_mov_b32 v241, v240
    s_nop 1
    v_permlane32_swap_b32 v240, v241
    v_max_f32 v240, v240, v241
    v_sub_f32 v9, v9, v240
    v_sub_f32 v112, v112, v240
    v_sub_f32 v128, v128, v240
    v_mov_b32 v160, v9
    v_sub_f32 v113, v113, v240
    v_sub_f32 v129, v129, v240
    v_mov_b32 v161, v9
    v_sub_f32 v114, v114, v240
    v_sub_f32 v130, v130, v240
    v_mov_b32 v162, v9
    v_sub_f32 v115, v115, v240
    v_sub_f32 v131, v131, v240
    v_mov_b32 v163, v9
    v_sub_f32 v116, v116, v240
    v_sub_f32 v132, v132, v240
    v_mov_b32 v164, v9
    v_sub_f32 v117, v117, v240
    v_sub_f32 v133, v133, v240
    v_mov_b32 v165, v9
    v_sub_f32 v118, v118, v240
    v_sub_f32 v134, v134, v240
    v_mov_b32 v166, v9
    v_sub_f32 v119, v119, v240
    v_sub_f32 v135, v135, v240
    v_mov_b32 v167, v9
    v_sub_f32 v120, v120, v240
    v_sub_f32 v136, v136, v240
    v_mov_b32 v168, v9
    v_sub_f32 v121, v121, v240
    v_sub_f32 v137, v137, v240
    v_mov_b32 v169, v9
    v_sub_f32 v122, v122, v240
    v_sub_f32 v138, v138, v240
    v_mov_b32 v170, v9
    v_sub_f32 v123, v123, v240
    v_sub_f32 v139, v139, v240
    v_mov_b32 v171, v9
    v_sub_f32 v124, v124, v240
    v_sub_f32 v140, v140, v240
    v_mov_b32 v172, v9
    v_sub_f32 v125, v125, v240
    v_sub_f32 v141, v141, v240
    v_mov_b32 v173, v9
    v_sub_f32 v126, v126, v240
    v_sub_f32 v142, v142, v240
    v_mov_b32 v174, v9
    v_sub_f32 v127, v127, v240
    v_sub_f32 v143, v143, v240
    v_mov_b32 v175, v9
    v_exp_f32 v252, v112
    v_exp_f32 v253, v113
    s_nop 0
    v_add_f32 v8, v252, v253
    v_cvt_pk_bf16_f32 v144, v252, v253
    v_exp_f32 v252, v114
    v_exp_f32 v253, v115
    s_nop 0
    v_add_f32 v8, v8, v252
    v_add_f32 v8, v8, v253
    v_cvt_pk_bf16_f32 v145, v252, v253
    v_exp_f32 v252, v116
    v_exp_f32 v253, v117
    s_nop 0
    v_add_f32 v8, v8, v252
    v_add_f32 v8, v8, v253
    v_cvt_pk_bf16_f32 v146, v252, v253
    v_exp_f32 v252, v118
    v_exp_f32 v253, v119
    s_nop 0
    v_add_f32 v8, v8, v252
    v_add_f32 v8, v8, v253
    v_cvt_pk_bf16_f32 v147, v252, v253
    v_exp_f32 v252, v120
    v_exp_f32 v253, v121
    s_nop 0
    v_add_f32 v8, v8, v252
    v_add_f32 v8, v8, v253
    v_cvt_pk_bf16_f32 v148, v252, v253
    v_exp_f32 v252, v122
    v_exp_f32 v253, v123
    s_nop 0
    v_add_f32 v8, v8, v252
    v_add_f32 v8, v8, v253
    v_cvt_pk_bf16_f32 v149, v252, v253
    v_exp_f32 v252, v124
    v_exp_f32 v253, v125
    s_nop 0
    v_add_f32 v8, v8, v252
    v_add_f32 v8, v8, v253
    v_cvt_pk_bf16_f32 v150, v252, v253
    v_exp_f32 v252, v126
    v_exp_f32 v253, v127
    s_nop 0
    v_add_f32 v8, v8, v252
    v_add_f32 v8, v8, v253
    v_cvt_pk_bf16_f32 v151, v252, v253
    s_branch L_ovfdone_i0
L_poll_odd:
    ds_read_b32 v13, v11
    s_waitcnt lgkmcnt(0)
    v_readfirstlane_b32 s52, v13
    s_cmp_ge_u32 s52, s48
    s_cbranch_scc1 L_polldone_odd
    s_sleep 1
    s_branch L_poll_odd
L_ovf_odd:
    s_nop 7
    s_nop 7
    v_max3_f32 v240, v128, v129, v130
    v_max3_f32 v241, v131, v132, v133
    v_max3_f32 v242, v134, v135, v136
    v_max3_f32 v243, v137, v138, v139
    v_max3_f32 v244, v140, v141, v142
    v_max3_f32 v240, v240, v241, v143
    v_max3_f32 v242, v242, v243, v244
    v_max_f32 v240, v240, v242
    v_mov_b32 v241, v240
    s_nop 1
    v_permlane32_swap_b32 v240, v241
    v_max_f32 v240, v240, v241
    v_max_f32 v240, 0, v240
    v_sub_f32 v241, 0, v240
    v_exp_f32 v241, v241
    v_sub_f32 v9, v9, v240
    v_sub_f32 v128, v128, v240
    v_sub_f32 v112, v112, v240
    v_mov_b32 v160, v9
    v_sub_f32 v129, v129, v240
    v_sub_f32 v113, v113, v240
    v_mov_b32 v161, v9
    v_sub_f32 v130, v130, v240
    v_sub_f32 v114, v114, v240
    v_mov_b32 v162, v9
    v_sub_f32 v131, v131, v240
    v_sub_f32 v115, v115, v240
    v_mov_b32 v163, v9
    v_sub_f32 v132, v132, v240
    v_sub_f32 v116, v116, v240
    v_mov_b32 v164, v9
    v_sub_f32 v133, v133, v240
    v_sub_f32 v117, v117, v240
    v_mov_b32 v165, v9
    v_sub_f32 v134, v134, v240
    v_sub_f32 v118, v118, v240
    v_mov_b32 v166, v9
    v_sub_f32 v135, v135, v240
    v_sub_f32 v119, v119, v240
    v_mov_b32 v167, v9
    v_sub_f32 v136, v136, v240
    v_sub_f32 v120, v120, v240
    v_mov_b32 v168, v9
    v_sub_f32 v137, v137, v240
    v_sub_f32 v121, v121, v240
    v_mov_b32 v169, v9
    v_sub_f32 v138, v138, v240
    v_sub_f32 v122, v122, v240
    v_mov_b32 v170, v9
    v_sub_f32 v139, v139, v240
    v_sub_f32 v123, v123, v240
    v_mov_b32 v171, v9
    v_sub_f32 v140, v140, v240
    v_sub_f32 v124, v124, v240
    v_mov_b32 v172, v9
    v_sub_f32 v141, v141, v240
    v_sub_f32 v125, v125, v240
    v_mov_b32 v173, v9
    v_sub_f32 v142, v142, v240
    v_sub_f32 v126, v126, v240
    v_mov_b32 v174, v9
    v_sub_f32 v143, v143, v240
    v_sub_f32 v127, v127, v240
    v_mov_b32 v175, v9
    v_mul_f32 v48, v241, v48
    v_mul_f32 v49, v241, v49
    v_mul_f32 v50, v241, v50
    v_mul_f32 v51, v241, v51
    v_mul_f32 v52, v241, v52
    v_mul_f32 v53, v241, v53
    v_mul_f32 v54, v241, v54
    v_mul_f32 v55, v241, v55
    v_mul_f32 v56, v241, v56
    v_mul_f32 v57, v241, v57
    v_mul_f32 v58, v241, v58
    v_mul_f32 v59, v241, v59
    v_mul_f32 v60, v241, v60
    v_mul_f32 v61, v241, v61
    v_mul_f32 v62, v241, v62
    v_mul_f32 v63, v241, v63
    v_mul_f32 v64, v241, v64
    v_mul_f32 v65, v241, v65
    v_mul_f32 v66, v241, v66
    v_mul_f32 v67, v241, v67
    v_mul_f32 v68, v241, v68
    v_mul_f32 v69, v241, v69
    v_mul_f32 v70, v241, v70
    v_mul_f32 v71, v241, v71
    v_mul_f32 v72, v241, v72
    v_mul_f32 v73, v241, v73
    v_mul_f32 v74, v241, v74
    v_mul_f32 v75, v241, v75
    v_mul_f32 v76, v241, v76
    v_mul_f32 v77, v241, v77
    v_mul_f32 v78, v241, v78
    v_mul_f32 v79, v241, v79
    v_mul_f32 v80, v241, v80
    v_mul_f32 v81, v241, v81
    v_mul_f32 v82, v241, v82
    v_mul_f32 v83, v241, v83
    v_mul_f32 v84, v241, v84
    v_mul_f32 v85, v241, v85
    v_mul_f32 v86, v241, v86
    v_mul_f32 v87, v241, v87
    v_mul_f32 v88, v241, v88
    v_mul_f32 v89, v241, v89
    v_mul_f32 v90, v241, v90
    v_mul_f32 v91, v241, v91
    v_mul_f32 v92, v241, v92
    v_mul_f32 v93, v241, v93
    v_mul_f32 v94, v241, v94
    v_mul_f32 v95, v241, v95
    v_mul_f32 v96, v241, v96
    v_mul_f32 v97, v241, v97
    v_mul_f32 v98, v241, v98
    v_mul_f32 v99, v241, v99
    v_mul_f32 v100, v241, v100
    v_mul_f32 v101, v241, v101
    v_mul_f32 v102, v241, v102
    v_mul_f32 v103, v241, v103
    v_mul_f32 v104, v241, v104
    v_mul_f32 v105, v241, v105
    v_mul_f32 v106, v241, v106
    v_mul_f32 v107, v241, v107
    v_mul_f32 v108, v241, v108
    v_mul_f32 v109, v241, v109
    v_mul_f32 v110, v241, v110
    v_mul_f32 v111, v241, v111
    v_mul_f32 v7, v241, v7
    v_exp_f32 v252, v128
    v_exp_f32 v253, v129
    s_nop 0
    v_add_f32 v8, v252, v253
    v_cvt_pk_bf16_f32 v152, v252, v253
    v_exp_f32 v252, v130
    v_exp_f32 v253, v131
    s_nop 0
    v_add_f32 v8, v8, v252
    v_add_f32 v8, v8, v253
    v_cvt_pk_bf16_f32 v153, v252, v253
    v_exp_f32 v252, v132
    v_exp_f32 v253, v133
    s_nop 0
    v_add_f32 v8, v8, v252
    v_add_f32 v8, v8, v253
    v_cvt_pk_bf16_f32 v154, v252, v253
    v_exp_f32 v252, v134
    v_exp_f32 v253, v135
    s_nop 0
    v_add_f32 v8, v8, v252
    v_add_f32 v8, v8, v253
    v_cvt_pk_bf16_f32 v155, v252, v253
    v_exp_f32 v252, v136
    v_exp_f32 v253, v137
    s_nop 0
    v_add_f32 v8, v8, v252
    v_add_f32 v8, v8, v253
    v_cvt_pk_bf16_f32 v156, v252, v253
    v_exp_f32 v252, v138
    v_exp_f32 v253, v139
    s_nop 0
    v_add_f32 v8, v8, v252
    v_add_f32 v8, v8, v253
    v_cvt_pk_bf16_f32 v157, v252, v253
    v_exp_f32 v252, v140
    v_exp_f32 v253, v141
    s_nop 0
    v_add_f32 v8, v8, v252
    v_add_f32 v8, v8, v253
    v_cvt_pk_bf16_f32 v158, v252, v253
    v_exp_f32 v252, v142
    v_exp_f32 v253, v143
    s_nop 0
    v_add_f32 v8, v8, v252
    v_add_f32 v8, v8, v253
    v_cvt_pk_bf16_f32 v159, v252, v253
    s_branch L_ovfdone_odd
L_poll_even:
    ds_read_b32 v13, v11
    s_waitcnt lgkmcnt(0)
    v_readfirstlane_b32 s52, v13
    s_cmp_ge_u32 s52, s48
    s_cbranch_scc1 L_polldone_even
    s_sleep 1
    s_branch L_poll_even
L_ovf_even:
    s_nop 7
    s_nop 7
    v_max3_f32 v240, v112, v113, v114
    v_max3_f32 v241, v115, v116, v117
    v_max3_f32 v242, v118, v119, v120
    v_max3_f32 v243, v121, v122, v123
    v_max3_f32 v244, v124, v125, v126
    v_max3_f32 v240, v240, v241, v127
    v_max3_f32 v242, v242, v243, v244
    v_max_f32 v240, v240, v242
    v_mov_b32 v241, v240
    s_nop 1
    v_permlane32_swap_b32 v240, v241
    v_max_f32 v240, v240, v241
    v_max_f32 v240, 0, v240
    v_sub_f32 v241, 0, v240
    v_exp_f32 v241, v241
    v_sub_f32 v9, v9, v240
    v_sub_f32 v112, v112, v240
    v_sub_f32 v128, v128, v240
    v_mov_b32 v160, v9
    v_sub_f32 v113, v113, v240
    v_sub_f32 v129, v129, v240
    v_mov_b32 v161, v9
    v_sub_f32 v114, v114, v240
    v_sub_f32 v130, v130, v240
    v_mov_b32 v162, v9
    v_sub_f32 v115, v115, v240
    v_sub_f32 v131, v131, v240
    v_mov_b32 v163, v9
    v_sub_f32 v116, v116, v240
    v_sub_f32 v132, v132, v240
    v_mov_b32 v164, v9
    v_sub_f32 v117, v117, v240
    v_sub_f32 v133, v133, v240
    v_mov_b32 v165, v9
    v_sub_f32 v118, v118, v240
    v_sub_f32 v134, v134, v240
    v_mov_b32 v166, v9
    v_sub_f32 v119, v119, v240
    v_sub_f32 v135, v135, v240
    v_mov_b32 v167, v9
    v_sub_f32 v120, v120, v240
    v_sub_f32 v136, v136, v240
    v_mov_b32 v168, v9
    v_sub_f32 v121, v121, v240
    v_sub_f32 v137, v137, v240
    v_mov_b32 v169, v9
    v_sub_f32 v122, v122, v240
    v_sub_f32 v138, v138, v240
    v_mov_b32 v170, v9
    v_sub_f32 v123, v123, v240
    v_sub_f32 v139, v139, v240
    v_mov_b32 v171, v9
    v_sub_f32 v124, v124, v240
    v_sub_f32 v140, v140, v240
    v_mov_b32 v172, v9
    v_sub_f32 v125, v125, v240
    v_sub_f32 v141, v141, v240
    v_mov_b32 v173, v9
    v_sub_f32 v126, v126, v240
    v_sub_f32 v142, v142, v240
    v_mov_b32 v174, v9
    v_sub_f32 v127, v127, v240
    v_sub_f32 v143, v143, v240
    v_mov_b32 v175, v9
    v_mul_f32 v48, v241, v48
    v_mul_f32 v49, v241, v49
    v_mul_f32 v50, v241, v50
    v_mul_f32 v51, v241, v51
    v_mul_f32 v52, v241, v52
    v_mul_f32 v53, v241, v53
    v_mul_f32 v54, v241, v54
    v_mul_f32 v55, v241, v55
    v_mul_f32 v56, v241, v56
    v_mul_f32 v57, v241, v57
    v_mul_f32 v58, v241, v58
    v_mul_f32 v59, v241, v59
    v_mul_f32 v60, v241, v60
    v_mul_f32 v61, v241, v61
    v_mul_f32 v62, v241, v62
    v_mul_f32 v63, v241, v63
    v_mul_f32 v64, v241, v64
    v_mul_f32 v65, v241, v65
    v_mul_f32 v66, v241, v66
    v_mul_f32 v67, v241, v67
    v_mul_f32 v68, v241, v68
    v_mul_f32 v69, v241, v69
    v_mul_f32 v70, v241, v70
    v_mul_f32 v71, v241, v71
    v_mul_f32 v72, v241, v72
    v_mul_f32 v73, v241, v73
    v_mul_f32 v74, v241, v74
    v_mul_f32 v75, v241, v75
    v_mul_f32 v76, v241, v76
    v_mul_f32 v77, v241, v77
    v_mul_f32 v78, v241, v78
    v_mul_f32 v79, v241, v79
    v_mul_f32 v80, v241, v80
    v_mul_f32 v81, v241, v81
    v_mul_f32 v82, v241, v82
    v_mul_f32 v83, v241, v83
    v_mul_f32 v84, v241, v84
    v_mul_f32 v85, v241, v85
    v_mul_f32 v86, v241, v86
    v_mul_f32 v87, v241, v87
    v_mul_f32 v88, v241, v88
    v_mul_f32 v89, v241, v89
    v_mul_f32 v90, v241, v90
    v_mul_f32 v91, v241, v91
    v_mul_f32 v92, v241, v92
    v_mul_f32 v93, v241, v93
    v_mul_f32 v94, v241, v94
    v_mul_f32 v95, v241, v95
    v_mul_f32 v96, v241, v96
    v_mul_f32 v97, v241, v97
    v_mul_f32 v98, v241, v98
    v_mul_f32 v99, v241, v99
    v_mul_f32 v100, v241, v100
    v_mul_f32 v101, v241, v101
    v_mul_f32 v102, v241, v102
    v_mul_f32 v103, v241, v103
    v_mul_f32 v104, v241, v104
    v_mul_f32 v105, v241, v105
    v_mul_f32 v106, v241, v106
    v_mul_f32 v107, v241, v107
    v_mul_f32 v108, v241, v108
    v_mul_f32 v109, v241, v109
    v_mul_f32 v110, v241, v110
    v_mul_f32 v111, v241, v111
    v_mul_f32 v7, v241, v7
    v_exp_f32 v252, v112
    v_exp_f32 v253, v113
    s_nop 0
    v_add_f32 v8, v252, v253
    v_cvt_pk_bf16_f32 v144, v252, v253
    v_exp_f32 v252, v114
    v_exp_f32 v253, v115
    s_nop 0
    v_add_f32 v8, v8, v252
    v_add_f32 v8, v8, v253
    v_cvt_pk_bf16_f32 v145, v252, v253
    v_exp_f32 v252, v116
    v_exp_f32 v253, v117
    s_nop 0
    v_add_f32 v8, v8, v252
    v_add_f32 v8, v8, v253
    v_cvt_pk_bf16_f32 v146, v252, v253
    v_exp_f32 v252, v118
    v_exp_f32 v253, v119
    s_nop 0
    v_add_f32 v8, v8, v252
    v_add_f32 v8, v8, v253
    v_cvt_pk_bf16_f32 v147, v252, v253
    v_exp_f32 v252, v120
    v_exp_f32 v253, v121
    s_nop 0
    v_add_f32 v8, v8, v252
    v_add_f32 v8, v8, v253
    v_cvt_pk_bf16_f32 v148, v252, v253
    v_exp_f32 v252, v122
    v_exp_f32 v253, v123
    s_nop 0
    v_add_f32 v8, v8, v252
    v_add_f32 v8, v8, v253
    v_cvt_pk_bf16_f32 v149, v252, v253
    v_exp_f32 v252, v124
    v_exp_f32 v253, v125
    s_nop 0
    v_add_f32 v8, v8, v252
    v_add_f32 v8, v8, v253
    v_cvt_pk_bf16_f32 v150, v252, v253
    v_exp_f32 v252, v126
    v_exp_f32 v253, v127
    s_nop 0
    v_add_f32 v8, v8, v252
    v_add_f32 v8, v8, v253
    v_cvt_pk_bf16_f32 v151, v252, v253
    s_branch L_ovfdone_even
L_ev_odd:
    s_cmp_eq_u32 s48, s47
    s_cbranch_scc1 L_fin_odd
    s_mov_b32 s49, s47
    v_sub_u32 v240, s50, v2
    v_cmp_lt_i32 s[86:87], 0, v240
    v_cmp_lt_i32 s[88:89], 1, v240
    v_cmp_lt_i32 s[90:91], 2, v240
    v_cmp_lt_i32 s[92:93], 3, v240
    v_cndmask_b32 v112, v10, v112, s[86:87]
    v_cndmask_b32 v113, v10, v113, s[88:89]
    v_cndmask_b32 v114, v10, v114, s[90:91]
    v_cndmask_b32 v115, v10, v115, s[92:93]
    v_cmp_lt_i32 s[86:87], 8, v240
    v_cmp_lt_i32 s[88:89], 9, v240
    v_cmp_lt_i32 s[90:91], 10, v240
    v_cmp_lt_i32 s[92:93], 11, v240
    v_cndmask_b32 v116, v10, v116, s[86:87]
    v_cndmask_b32 v117, v10, v117, s[88:89]
    v_cndmask_b32 v118, v10, v118, s[90:91]
    v_cndmask_b32 v119, v10, v119, s[92:93]
    v_cmp_lt_i32 s[86:87], 16, v240
    v_cmp_lt_i32 s[88:89], 17, v240
    v_cmp_lt_i32 s[90:91], 18, v240
    v_cmp_lt_i32 s[92:93], 19, v240
    v_cndmask_b32 v120, v10, v120, s[86:87]
    v_cndmask_b32 v121, v10, v121, s[88:89]
    v_cndmask_b32 v122, v10, v122, s[90:91]
    v_cndmask_b32 v123, v10, v123, s[92:93]
    v_cmp_lt_i32 s[86:87], 24, v240
    v_cmp_lt_i32 s[88:89], 25, v240
    v_cmp_lt_i32 s[90:91], 26, v240
    v_cmp_lt_i32 s[92:93], 27, v240
    v_cndmask_b32 v124, v10, v124, s[86:87]
    v_cndmask_b32 v125, v10, v125, s[88:89]
    v_cndmask_b32 v126, v10, v126, s[90:91]
    v_cndmask_b32 v127, v10, v127, s[92:93]
    s_branch L_loop_mid
L_ev_even:
    s_cmp_eq_u32 s48, s47
    s_cbranch_scc1 L_fin_even
    s_mov_b32 s49, s47
    v_sub_u32 v240, s50, v2
    v_cmp_lt_i32 s[86:87], 0, v240
    v_cmp_lt_i32 s[88:89], 1, v240
    v_cmp_lt_i32 s[90:91], 2, v240
    v_cmp_lt_i32 s[92:93], 3, v240
    v_cndmask_b32 v128, v10, v128, s[86:87]
    v_cndmask_b32 v129, v10, v129, s[88:89]
    v_cndmask_b32 v130, v10, v130, s[90:91]
    v_cndmask_b32 v131, v10, v131, s[92:93]
    v_cmp_lt_i32 s[86:87], 8, v240
    v_cmp_lt_i32 s[88:89], 9, v240
    v_cmp_lt_i32 s[90:91], 10, v240
    v_cmp_lt_i32 s[92:93], 11, v240
    v_cndmask_b32 v132, v10, v132, s[86:87]
    v_cndmask_b32 v133, v10, v133, s[88:89]
    v_cndmask_b32 v134, v10, v134, s[90:91]
    v_cndmask_b32 v135, v10, v135, s[92:93]
    v_cmp_lt_i32 s[86:87], 16, v240
    v_cmp_lt_i32 s[88:89], 17, v240
    v_cmp_lt_i32 s[90:91], 18, v240
    v_cmp_lt_i32 s[92:93], 19, v240
    v_cndmask_b32 v136, v10, v136, s[86:87]
    v_cndmask_b32 v137, v10, v137, s[88:89]
    v_cndmask_b32 v138, v10, v138, s[90:91]
    v_cndmask_b32 v139, v10, v139, s[92:93]
    v_cmp_lt_i32 s[86:87], 24, v240
    v_cmp_lt_i32 s[88:89], 25, v240
    v_cmp_lt_i32 s[90:91], 26, v240
    v_cmp_lt_i32 s[92:93], 27, v240
    v_cndmask_b32 v140, v10, v140, s[86:87]
    v_cndmask_b32 v141, v10, v141, s[88:89]
    v_cndmask_b32 v142, v10, v142, s[90:91]
    v_cndmask_b32 v143, v10, v143, s[92:93]
    s_branch L_loop
L_codeend:
    s_endpgm
.section .rodata,"a"
.p2align 6
.amdhsa_kernel standalone__ragged_sequences_packed_sequences__ragged_kernel
  .amdhsa_next_free_vgpr 256
  .amdhsa_next_free_sgpr 96
  .amdhsa_accum_offset 256
  .amdhsa_group_segment_fixed_size 0
  .amdhsa_kernarg_size 56
  .amdhsa_user_sgpr_count 2
  .amdhsa_user_sgpr_kernarg_segment_ptr 1
  .amdhsa_system_sgpr_workgroup_id_x 1
.end_amdhsa_kernel
```
